```python
import torch

def _softmax(x, axis=-1):
    return torch.softmax(x, dim=axis)
def _gelu(x):
    return torch.nn.functional.gelu(x, approximate="tanh")
def _silu(x):
    return torch.nn.functional.silu(x)
def _sigmoid(x):
    return torch.sigmoid(x)
def _layernorm(x, axis=-1, eps=1e-5):
    m = x.mean(dim=axis, keepdim=True)
    v = x.var(dim=axis, keepdim=True, unbiased=False)
    return (x - m) / torch.sqrt(v + eps)
def _scatter_add(tgt, idx, src, axis=0):
    return tgt.clone().index_add_(axis, idx, src)
def _segment_sum(src, seg, n):
    out = torch.zeros((n,) + src.shape[1:], dtype=src.dtype)
    return out.index_add_(0, seg, src)
def _pad(x, pw):
    flat = tuple(v for pair in reversed(pw) for v in pair)
    return torch.nn.functional.pad(x, flat)

kernel_name = 'standalone__depthwise_separable__vision'

def setup_inputs():

    _w = (lambda a: (lambda t: t.to(torch.bfloat16) if t.is_floating_point() else t)(torch.as_tensor(a)))
    H = W = 512
    C = 96
    k = 1
    return {
        "x": _w((lambda *s: torch.randn(*s, dtype=torch.bfloat16) * 0.05)(1, H, W, C)),
        "dw": _w((lambda *s: torch.randn(*s, dtype=torch.bfloat16) * 0.05)(k, k, C)),
        "pw": _w((lambda *s: torch.randn(*s, dtype=torch.bfloat16) * 0.05)(C, C)),
    }

def reference(x, dw, pw):
    B, H, W, C = x.shape
    k = dw.shape[0]
    pad = k // 2
    xp = _pad(x, ((0,0),(pad,pad),(pad,pad),(0,0)))
    out = torch.zeros_like(x)
    for i in range(k):
        for j in range(k):
            out = out + xp[:, i:i+H, j:j+W, :] * dw[i, j][None, None, None, :]
    return torch.einsum('bhwc,cd->bhwd', out, pw)
```

```asm
; @launch grid=(256,1,1) block=(512,1,1) lds=94272
.amdgcn_target "amdgcn-amd-amdhsa--gfx950"
.text
.globl standalone__depthwise_separable__vision_kernel
.p2align 8
.type standalone__depthwise_separable__vision_kernel,@function
standalone__depthwise_separable__vision_kernel:
  s_cmp_ge_u32 s2, 256
  s_cbranch_scc1 L_end
  s_load_dwordx8 s[4:11], s[0:1], 0
  s_load_dwordx4 s[44:47], s[0:1], 32
  s_memtime s[54:55]
  v_lshrrev_b32 v9, 6, v0
  v_and_b32 v0, 63, v0
  v_readfirstlane_b32 s28, v9
  v_lshlrev_b32 v1, 4, v0
  s_cmp_lg_u32 s28, 7
  s_cbranch_scc1 L_nocpf
  s_getpc_b64 s[56:57]
L_pc:
  v_min_u32 v96, 23, v0
  v_lshlrev_b32 v96, 7, v96
  global_load_dword v24, v96, s[56:57] offset:64
L_nocpf:
  s_lshr_b32 s27, s2, 6
  s_mul_i32 s29, s27, 12582912
  s_sub_u32 s35, s28, 1
  s_lshr_b32 s36, s35, 1
  s_and_b32 s35, s35, 1
  s_mulk_i32 s36, 3072
  s_mul_i32 s61, s35, 9224
  s_add_u32 m0, s61, s36
  s_mulk_i32 s35, 1536
  s_lshl1_add_u32 s60, s36, s35
  s_movk_i32 s22, 1536
  s_add_u32 s61, s60, s22
  v_lshrrev_b32 v96, 5, v0
  v_mad_u32_u24 v96, v96, s22, v1
  s_movk_i32 s22, 18432
  s_mov_b32 s23, 0x20000
  s_add_u32 s62, s29, 6291456
  s_waitcnt lgkmcnt(0)
  s_bfe_u32 s54, s54, 0xe0002
  s_lshl_b32 s54, s54, 7
  s_add_u32 s62, s62, s54
  v_mov_b32 v98, s62
  v_xor_b32 v99, 8192, v98
  s_cmp_lg_u32 s28, 0
.p2align 6, , 48
L_probe:
  s_barrier
  s_cbranch_scc1 L_notw0
  s_mov_b64 exec, 1
  global_load_dword v60, v98, s[4:5] nt
  global_load_dword v61, v99, s[4:5] nt
  s_waitcnt vmcnt(1)
  s_memtime s[54:55]
  s_waitcnt vmcnt(0)
  s_memtime s[56:57]
L_probe_end:
  s_mov_b64 exec, -1
  s_lshr_b32 s61, s62, 8
  s_xor_b32 s60, s62, s61
  v_mov_b32 v10, 94208
  v_mov_b32 v97, 2
  v_mov_b32 v98, 0
  s_waitcnt lgkmcnt(0)
  s_sub_u32 s61, s56, s54
  s_lshr_b32 s60, s60, 13
  s_cmp_lt_u32 s61, 16
  s_addc_u32 s61, s60, 0
  s_and_b32 s61, s61, 1
  v_mov_b32 v96, s61
  ds_write_b96 v10, v[96:98]
  s_branch L_claim
L_notw0:
  s_cmp_eq_u32 s28, 7
  s_cbranch_scc1 L_dw
  s_mov_b32 s20, s8
  s_mov_b32 s21, s9
  buffer_load_dwordx4 v1, s[20:23], s60 offen lds
  buffer_load_dwordx4 v96, s[20:23], s60 offen offset:1024 lds
  buffer_load_dwordx4 v1, s[20:23], s61 offen offset:2048 lds
  s_branch L_xload
L_claim:
  s_getreg_b32 s63, hwreg(HW_REG_XCC_ID, 2, 1)
  s_xor_b32 s63, s63, s61
  s_lshl2_add_u32 s63, s63, s61
  s_or_b32 s63, s63, 2
  s_lshl_b32 s58, s2, 2
  s_lshl_b32 s63, s63, s58
  s_andn2_b32 s62, s2, 15
  s_bfe_u32 s60, s2, 0x10003
  s_lshl2_add_u32 s62, s60, s62
  s_waitcnt lgkmcnt(0)
  s_atomic_or s63, s[44:45], s62 glc
  s_barrier
  s_branch L_xload
L_dw:
  s_mov_b32 m0, 18688
  s_mov_b32 s20, s6
  s_mov_b32 s21, s7
  s_mov_b32 s22, 192
  buffer_load_dwordx4 v1, s[20:23], 0 offen lds
L_xload:
  v_xor_b32 v3, 32, v1
  v_and_b32 v9, 32, v0
  v_xor_b32 v2, v9, v1
  s_and_b32 s35, s2, 63
  s_lshl_b32 s35, s35, 3
  s_add_u32 s35, s35, s28
  s_mul_i32 s64, s35, 3072
  s_add_u32 s64, s64, s29
  s_mul_i32 s33, s28, 6144
  s_add_u32 s33, s33, 45056
  s_mov_b32 m0, s33
  s_mov_b32 s12, s4
  s_mov_b32 s13, s5
  s_mov_b32 s14, 50331648
  s_mov_b32 s15, 0x20000
  buffer_load_dwordx4 v1, s[12:15], s64 offen offset:0 nt lds
  buffer_load_dwordx4 v2, s[12:15], s64 offen offset:1024 nt lds
  buffer_load_dwordx4 v3, s[12:15], s64 offen offset:2048 nt lds
  s_cmp_eq_u32 s35, 5
  s_cbranch_scc1 L_clear
L_cleared:
  s_lshr_b32 s35, s2, 1
  s_and_b32 s35, s35, 28
  s_and_b32 s42, s2, 3
  s_or_b32 s42, s42, s35
  s_mul_i32 s34, s42, 49152
  s_add_u32 s34, s34, s29
  s_add_u32 s34, s34, 1572864
  s_mov_b32 s41, s34
  s_add_u32 s29, s29, 7864320
  s_xor_b32 s35, s28, s42
  s_and_b32 s35, s35, 7
  s_lshl_b32 s25, s27, 3
  s_or_b32 s25, s25, s35
  s_lshl_b32 s25, s25, 8
  s_lshl_b32 s35, s35, 2
  s_lshr_b32 s39, 0xcb756210, s35
  s_mov_b32 s16, s10
  s_mov_b32 s17, s11
  s_mov_b32 s18, 50331648
  s_mov_b32 s19, 0x20000
  s_mov_b32 s32, 0xffff0000
  s_mov_b32 s24, 0
  s_mov_b32 s67, 0
  s_sub_u32 s71, s28, 4
  s_mul_i32 s71, s71, 4
  s_sub_u32 s71, 44, s71
  s_cmp_lt_u32 s28, 4
  s_cselect_b32 s71, -1, s71
  s_and_b32 s35, s2, 63
  s_cselect_b32 s71, s71, -1
  s_mov_b32 s31, 2
  s_mov_b32 s66, 3072
  s_mul_i32 s35, s28, 3072
  s_add_u32 s35, s35, 20480
  v_mov_b32 v10, 94208
  v_and_b32 v9, 48, v0
  v_and_b32 v96, 15, v0
  v_mul_u32_u24 v97, 192, v96
  v_and_b32 v98, 8, v0
  v_lshlrev_b32 v98, 2, v98
  v_xor_b32 v98, v98, v9
  v_add3_u32 v4, v97, v98, s33
  v_and_b32 v98, 6, v0
  v_lshlrev_b32 v98, 3, v98
  v_xor_b32 v98, v98, v9
  v_add3_u32 v5, v97, v98, s35
  v_add_u32 v96, 0, v0
  v_mul_u32_u24 v97, 171, v96
  v_bfe_u32 v97, v97, 12, 2
  v_xor_b32 v96, v96, v97
  v_lshl_add_u32 v6, v96, 4, s35
  v_add_u32 v96, 64, v0
  v_mul_u32_u24 v97, 171, v96
  v_bfe_u32 v97, v97, 12, 2
  v_xor_b32 v96, v96, v97
  v_lshl_add_u32 v7, v96, 4, s35
  v_add_u32 v96, 128, v0
  v_mul_u32_u24 v97, 171, v96
  v_bfe_u32 v97, v97, 12, 2
  v_xor_b32 v96, v96, v97
  v_lshl_add_u32 v8, v96, 4, s35
  v_bfe_u32 v96, v0, 4, 1
  v_mul_u32_u24 v96, 9224, v96
  v_lshrrev_b32 v97, 5, v0
  v_lshlrev_b32 v97, 3, v97
  v_bfe_u32 v98, v0, 2, 2
  v_add_u32 v97, v97, v98
  v_mul_u32_u24 v97, 192, v97
  v_and_b32 v98, 3, v0
  v_lshlrev_b32 v98, 4, v98
  v_add3_u32 v96, v96, v97, v98
  s_add_u32 s35, s33, 3072
  s_mov_b32 m0, s35
  s_cmp_eq_u32 s28, 0
  s_cbranch_scc1 L_w0pref
  s_waitcnt vmcnt(3)
  s_barrier
  ds_read_b32 v97, v10
  s_waitcnt lgkmcnt(0)
  v_readfirstlane_b32 s61, v97
L_w0pref:
  ds_read_b128 v[60:63], v9 offset:18688
  ds_read_b128 v[64:67], v9 offset:18752
  ds_read_b128 v[68:71], v9 offset:18816
  s_mov_b32 s37, s61
  s_add_u32 s36, s41, 24576
  s_lshr_b32 s36, s36, 21
  s_xor_b32 s36, s36, s37
  s_lshl_b32 s36, s36, 3
  s_xor_b32 s36, s36, s39
  s_and_b32 s36, s36, 15
  s_mul_i32 s36, s36, 3072
  s_add_u32 s65, s36, s41
  buffer_load_dwordx4 v1, s[12:15], s65 offen offset:0 nt lds
  buffer_load_dwordx4 v2, s[12:15], s65 offen offset:1024 nt lds
  buffer_load_dwordx4 v3, s[12:15], s65 offen offset:2048 nt lds
  ds_read_b64_tr_b16 v[100:101], v96 offset:0
  ds_read_b64_tr_b16 v[102:103], v96 offset:768
  ds_read_b64_tr_b16 v[112:113], v96 offset:8
  ds_read_b64_tr_b16 v[114:115], v96 offset:776
  ds_read_b64_tr_b16 v[124:125], v96 offset:64
  ds_read_b64_tr_b16 v[126:127], v96 offset:832
  ds_read_b64_tr_b16 v[136:137], v96 offset:72
  ds_read_b64_tr_b16 v[138:139], v96 offset:840
  ds_read_b64_tr_b16 v[148:149], v96 offset:128
  ds_read_b64_tr_b16 v[150:151], v96 offset:896
  ds_read_b64_tr_b16 v[160:161], v96 offset:136
  ds_read_b64_tr_b16 v[162:163], v96 offset:904
  ds_read_b64_tr_b16 v[104:105], v96 offset:3072
  ds_read_b64_tr_b16 v[106:107], v96 offset:3840
  ds_read_b64_tr_b16 v[116:117], v96 offset:3080
  ds_read_b64_tr_b16 v[118:119], v96 offset:3848
  ds_read_b64_tr_b16 v[128:129], v96 offset:3136
  ds_read_b64_tr_b16 v[130:131], v96 offset:3904
  ds_read_b64_tr_b16 v[140:141], v96 offset:3144
  ds_read_b64_tr_b16 v[142:143], v96 offset:3912
  ds_read_b64_tr_b16 v[152:153], v96 offset:3200
  ds_read_b64_tr_b16 v[154:155], v96 offset:3968
  ds_read_b64_tr_b16 v[164:165], v96 offset:3208
  ds_read_b64_tr_b16 v[166:167], v96 offset:3976
  ds_read_b64_tr_b16 v[108:109], v96 offset:6144
  ds_read_b64_tr_b16 v[110:111], v96 offset:6912
  ds_read_b64_tr_b16 v[120:121], v96 offset:6152
  ds_read_b64_tr_b16 v[122:123], v96 offset:6920
  ds_read_b64_tr_b16 v[132:133], v96 offset:6208
  ds_read_b64_tr_b16 v[134:135], v96 offset:6976
  ds_read_b64_tr_b16 v[144:145], v96 offset:6216
  ds_read_b64_tr_b16 v[146:147], v96 offset:6984
  ds_read_b64_tr_b16 v[156:157], v96 offset:6272
  ds_read_b64_tr_b16 v[158:159], v96 offset:7040
  ds_read_b64_tr_b16 v[168:169], v96 offset:6280
  ds_read_b64_tr_b16 v[170:171], v96 offset:7048
  s_waitcnt lgkmcnt(0)
  s_cmp_lg_u32 s28, 0
  s_cbranch_scc1 L_nopub
  s_xor_b32 s58, s58, 16
  s_lshr_b32 s63, s63, s58
  s_xor_b32 s62, s63, 1
  s_and_b32 s62, s62, 1
  s_bitcmp1_b32 s63, 1
  s_cselect_b32 s61, s62, s61
  v_mov_b32 v96, s61
  ds_write_b32 v10, v96 offset:4
L_nopub:
  v_lshlrev_b32 v72, 16, v60
  v_and_b32 v73, s32, v60
  v_lshlrev_b32 v74, 16, v61
  v_and_b32 v75, s32, v61
  v_lshlrev_b32 v76, 16, v62
  v_and_b32 v77, s32, v62
  v_lshlrev_b32 v78, 16, v63
  v_and_b32 v79, s32, v63
  v_lshlrev_b32 v80, 16, v64
  v_and_b32 v81, s32, v64
  v_lshlrev_b32 v82, 16, v65
  v_and_b32 v83, s32, v65
  v_lshlrev_b32 v84, 16, v66
  v_and_b32 v85, s32, v66
  v_lshlrev_b32 v86, 16, v67
  v_and_b32 v87, s32, v67
  v_lshlrev_b32 v88, 16, v68
  v_and_b32 v89, s32, v68
  v_lshlrev_b32 v90, 16, v69
  v_and_b32 v91, s32, v69
  v_lshlrev_b32 v92, 16, v70
  v_and_b32 v93, s32, v70
  v_lshlrev_b32 v94, 16, v71
  v_and_b32 v95, s32, v71
  s_waitcnt vmcnt(3)
L_body:
  ds_read_b128 v[12:15], v4 offset:0
  ds_read_b128 v[16:19], v4 offset:64
  ds_read_b128 v[20:23], v4 offset:128
  s_branch L_body2
L_loop:
  s_cmp_le_u32 s31, 5
  s_cbranch_scc1 L_early
  s_cmp_ge_u32 s67, s71
  s_cbranch_scc1 L_nomore
L_req:
  s_mov_b32 s40, s26
  s_atomic_add s40, s[46:47], s25 glc
  s_lshl_b32 s35, s37, 4
  s_waitcnt lgkmcnt(0)
  s_lshr_b32 s41, s40, s35
  s_and_b32 s41, s41, 0xffff
  s_max_u32 s67, s67, s41
  s_cmp_ge_u32 s41, 96
  s_cbranch_scc1 L_dry
  s_mul_i32 s41, s41, 49152
  s_add_u32 s41, s41, s29
L_havespan:
  s_add_u32 s36, s41, 24576
  s_lshr_b32 s36, s36, 21
  s_xor_b32 s36, s36, s37
  s_lshl_b32 s36, s36, 3
  s_xor_b32 s36, s36, s39
  s_and_b32 s36, s36, 15
  s_mul_i32 s36, s36, 3072
  s_add_u32 s65, s36, s41
  s_waitcnt vmcnt(3)
  ds_read_b128 v[12:15], v4 offset:0
  ds_read_b128 v[16:19], v4 offset:64
  ds_read_b128 v[20:23], v4 offset:128
  buffer_load_dwordx4 v1, s[12:15], s65 offen offset:0 nt lds
  buffer_load_dwordx4 v2, s[12:15], s65 offen offset:1024 nt lds
  buffer_load_dwordx4 v3, s[12:15], s65 offen offset:2048 nt lds
L_body2:
  s_mov_b32 m0, s33
  s_add_u32 s33, s33, s66
  v_add_u32 v4, s66, v4
  s_sub_u32 s66, 0, s66
  s_waitcnt lgkmcnt(2)
  v_lshlrev_b32 v96, 16, v12
  v_and_b32 v97, s32, v12
  v_mul_f32 v96, v96, v72
  v_mul_f32 v97, v97, v73
  v_cvt_pk_bf16_f32 v12, v96, v97
  v_lshlrev_b32 v98, 16, v13
  v_and_b32 v99, s32, v13
  v_mul_f32 v98, v98, v74
  v_mul_f32 v99, v99, v75
  v_cvt_pk_bf16_f32 v13, v98, v99
  v_lshlrev_b32 v96, 16, v14
  v_and_b32 v97, s32, v14
  v_mul_f32 v96, v96, v76
  v_mul_f32 v97, v97, v77
  v_cvt_pk_bf16_f32 v14, v96, v97
  v_lshlrev_b32 v98, 16, v15
  v_and_b32 v99, s32, v15
  v_mul_f32 v98, v98, v78
  v_mul_f32 v99, v99, v79
  v_cvt_pk_bf16_f32 v15, v98, v99
  s_waitcnt lgkmcnt(0)
  v_lshlrev_b32 v96, 16, v16
  v_and_b32 v97, s32, v16
  v_mfma_f32_16x16x32_bf16 v[24:27], v[100:103], v[12:15], 0
  v_mul_f32 v96, v96, v80
  v_mul_f32 v97, v97, v81
  v_cvt_pk_bf16_f32 v16, v96, v97
  v_mfma_f32_16x16x32_bf16 v[28:31], v[112:115], v[12:15], 0
  v_lshlrev_b32 v98, 16, v17
  v_and_b32 v99, s32, v17
  v_mul_f32 v98, v98, v82
  v_mfma_f32_16x16x32_bf16 v[32:35], v[124:127], v[12:15], 0
  v_mul_f32 v99, v99, v83
  v_cvt_pk_bf16_f32 v17, v98, v99
  v_lshlrev_b32 v96, 16, v18
  v_mfma_f32_16x16x32_bf16 v[36:39], v[136:139], v[12:15], 0
  v_and_b32 v97, s32, v18
  v_mul_f32 v96, v96, v84
  v_mul_f32 v97, v97, v85
  v_mfma_f32_16x16x32_bf16 v[40:43], v[148:151], v[12:15], 0
  v_cvt_pk_bf16_f32 v18, v96, v97
  v_lshlrev_b32 v98, 16, v19
  v_and_b32 v99, s32, v19
  v_mfma_f32_16x16x32_bf16 v[44:47], v[160:163], v[12:15], 0
  v_mul_f32 v98, v98, v86
  v_mul_f32 v99, v99, v87
  v_cvt_pk_bf16_f32 v19, v98, v99
  v_lshlrev_b32 v96, 16, v20
  v_and_b32 v97, s32, v20
  v_mfma_f32_16x16x32_bf16 v[24:27], v[104:107], v[16:19], v[24:27]
  v_mul_f32 v96, v96, v88
  v_mul_f32 v97, v97, v89
  v_cvt_pk_bf16_f32 v20, v96, v97
  v_mfma_f32_16x16x32_bf16 v[28:31], v[116:119], v[16:19], v[28:31]
  v_lshlrev_b32 v98, 16, v21
  v_and_b32 v99, s32, v21
  v_mul_f32 v98, v98, v90
  v_mfma_f32_16x16x32_bf16 v[32:35], v[128:131], v[16:19], v[32:35]
  v_mul_f32 v99, v99, v91
  v_cvt_pk_bf16_f32 v21, v98, v99
  v_lshlrev_b32 v96, 16, v22
  v_mfma_f32_16x16x32_bf16 v[36:39], v[140:143], v[16:19], v[36:39]
  v_and_b32 v97, s32, v22
  v_mul_f32 v96, v96, v92
  v_mul_f32 v97, v97, v93
  v_mfma_f32_16x16x32_bf16 v[40:43], v[152:155], v[16:19], v[40:43]
  v_cvt_pk_bf16_f32 v22, v96, v97
  v_lshlrev_b32 v98, 16, v23
  v_and_b32 v99, s32, v23
  v_mfma_f32_16x16x32_bf16 v[44:47], v[164:167], v[16:19], v[44:47]
  v_mul_f32 v98, v98, v94
  v_mul_f32 v99, v99, v95
  v_cvt_pk_bf16_f32 v23, v98, v99
  s_nop 1
  v_mfma_f32_16x16x32_bf16 v[24:27], v[108:111], v[20:23], v[24:27]
  v_mfma_f32_16x16x32_bf16 v[28:31], v[120:123], v[20:23], v[28:31]
  v_mfma_f32_16x16x32_bf16 v[32:35], v[132:135], v[20:23], v[32:35]
  v_mfma_f32_16x16x32_bf16 v[36:39], v[144:147], v[20:23], v[36:39]
  v_mfma_f32_16x16x32_bf16 v[40:43], v[156:159], v[20:23], v[40:43]
  v_mfma_f32_16x16x32_bf16 v[44:47], v[168:171], v[20:23], v[44:47]
  s_nop 2
  v_cvt_pk_bf16_f32 v48, v24, v25
  v_cvt_pk_bf16_f32 v49, v26, v27
  v_cvt_pk_bf16_f32 v50, v28, v29
  v_cvt_pk_bf16_f32 v51, v30, v31
  ds_write_b128 v5, v[48:51] offset:0
  v_cvt_pk_bf16_f32 v52, v32, v33
  v_cvt_pk_bf16_f32 v53, v34, v35
  v_cvt_pk_bf16_f32 v54, v36, v37
  v_cvt_pk_bf16_f32 v55, v38, v39
  ds_write_b128 v5, v[52:55] offset:64
  v_cvt_pk_bf16_f32 v56, v40, v41
  v_cvt_pk_bf16_f32 v57, v42, v43
  v_cvt_pk_bf16_f32 v58, v44, v45
  v_cvt_pk_bf16_f32 v59, v46, v47
  ds_write_b128 v5, v[56:59] offset:128
  ds_read_b128 v[60:63], v6
  ds_read_b128 v[64:67], v7
  ds_read_b128 v[68:71], v8
  s_cmp_ge_u32 s67, 96
  s_cbranch_scc1 L_st2
  s_waitcnt lgkmcnt(2)
  buffer_store_dwordx4 v[60:63], v1, s[16:19], s64 offen offset:0 sc0 sc1
  s_waitcnt lgkmcnt(1)
  buffer_store_dwordx4 v[64:67], v1, s[16:19], s64 offen offset:1024 sc0 sc1
  s_waitcnt lgkmcnt(0)
  buffer_store_dwordx4 v[68:71], v1, s[16:19], s64 offen offset:2048 sc0 sc1
L_stored:
  s_mov_b32 s64, s65
  s_cmp_eq_u32 s24, 0
  s_cbranch_scc1 L_loop
L_end:
  s_endpgm
L_st2:
  s_waitcnt lgkmcnt(2)
  buffer_store_dwordx4 v[60:63], v1, s[16:19], s64 offen offset:0
  s_waitcnt lgkmcnt(1)
  buffer_store_dwordx4 v[64:67], v1, s[16:19], s64 offen offset:1024
  s_waitcnt lgkmcnt(0)
  buffer_store_dwordx4 v[68:71], v1, s[16:19], s64 offen offset:2048
  s_branch L_stored
L_early:
  s_add_u32 s31, s31, 1
  s_cmp_gt_u32 s31, 5
  s_cbranch_scc1 L_first
  s_cmp_lg_u32 s31, 3
  s_cbranch_scc1 L_clsok
L_pollcls:
  ds_read_b32 v96, v10 offset:4
  s_waitcnt lgkmcnt(0)
  v_readfirstlane_b32 s35, v96
  s_cmp_eq_u32 s35, 2
  s_cbranch_scc1 L_pollcls
  s_cmp_lg_u32 s35, s37
  s_cbranch_scc1 L_fix
L_clsok:
  s_add_u32 s34, s34, 1572864
  s_mov_b32 s41, s34
  s_cmp_lg_u32 s28, 1
  s_cbranch_scc1 L_havespan
  s_cmp_lg_u32 s31, 5
  s_cbranch_scc1 L_havespan
  s_andn2_b32 s62, s2, 15
  s_cmp_eq_u32 s27, 2
  s_cselect_b32 s60, 64, 0
  s_cselect_b32 s63, 7, 3
  s_add_u32 s62, s62, s60
  s_mov_b32 s60, 0
L_repoll:
  s_mov_b64 s[56:57], 0
  s_atomic_or_x2 s[56:57], s[44:45], s62 glc
  s_add_u32 s60, s60, 1
  s_waitcnt lgkmcnt(0)
  s_bitcmp1_b32 s56, s63
  s_cbranch_scc1 L_ready
  s_sleep 4
  s_cmp_lt_u32 s60, 2000
  s_cbranch_scc1 L_repoll
  s_and_b32 s35, s2, 63
  s_cbranch_scc0 L_repoll
  s_mov_b32 s61, 2
  s_branch L_pubrdy
L_ready:
  s_mov_b32 s54, 0x22222222
  s_mov_b32 s55, s54
  s_and_b64 s[52:53], s[56:57], s[54:55]
  s_bcnt1_i32_b64 s60, s[52:53]
  s_lshr_b64 s[56:57], s[56:57], 1
  s_and_b64 s[52:53], s[56:57], s[54:55]
  s_bcnt1_i32_b64 s61, s[52:53]
  s_lshl_b32 s61, s61, 1
  s_getreg_b32 s52, hwreg(HW_REG_XCC_ID, 2, 1)
  s_cmp_gt_u32 s61, s60
  s_addc_u32 s52, s52, 0
  s_and_b32 s52, s52, 1
  s_cmp_eq_u32 s61, s60
  s_cselect_b32 s61, s37, s52
  s_or_b32 s61, s61, 4
L_pubrdy:
  v_mov_b32 v96, s61
  ds_write_b32 v10, v96 offset:8
  s_branch L_havespan
L_first:
  ds_read_b32 v96, v10 offset:8
  s_waitcnt lgkmcnt(0)
  v_readfirstlane_b32 s35, v96
  s_cmp_eq_u32 s35, 0
  s_cbranch_scc1 L_first
  s_and_b32 s37, s35, 1
  s_lshl_b32 s36, s37, 4
  s_lshl_b32 s26, 1, s36
  s_cmp_lg_u32 s35, 2
  s_cbranch_scc1 L_req
  s_branch L_nomore
L_dry:
  s_xor_b32 s35, s35, 16
  s_lshr_b32 s41, s40, s35
  s_and_b32 s41, s41, 0xffff
  s_xor_b32 s37, s37, 1
  s_lshl_b32 s26, 1, s35
  s_cmp_lt_u32 s41, 96
  s_cbranch_scc1 L_req
L_nomore:
  s_mov_b32 s24, 1
  s_waitcnt vmcnt(3)
  s_branch L_body
L_fix:
  s_mov_b32 s37, s35
  s_mov_b32 s60, m0
  s_mov_b32 m0, s33
  s_add_u32 s36, s41, 24576
  s_lshr_b32 s36, s36, 21
  s_xor_b32 s36, s36, s37
  s_lshl_b32 s36, s36, 3
  s_xor_b32 s36, s36, s39
  s_and_b32 s36, s36, 15
  s_mul_i32 s36, s36, 3072
  s_add_u32 s64, s36, s41
  s_waitcnt vmcnt(3)
  buffer_load_dwordx4 v1, s[12:15], s64 offen offset:0 nt lds
  buffer_load_dwordx4 v2, s[12:15], s64 offen offset:1024 nt lds
  buffer_load_dwordx4 v3, s[12:15], s64 offen offset:2048 nt lds
  s_mov_b32 m0, s60
  s_add_u32 s34, s34, 1572864
  s_mov_b32 s41, s34
  s_add_u32 s36, s41, 24576
  s_lshr_b32 s36, s36, 21
  s_xor_b32 s36, s36, s37
  s_lshl_b32 s36, s36, 3
  s_xor_b32 s36, s36, s39
  s_and_b32 s36, s36, 15
  s_mul_i32 s36, s36, 3072
  s_add_u32 s65, s36, s41
  buffer_load_dwordx4 v1, s[12:15], s65 offen offset:0 nt lds
  buffer_load_dwordx4 v2, s[12:15], s65 offen offset:1024 nt lds
  buffer_load_dwordx4 v3, s[12:15], s65 offen offset:2048 nt lds
  s_waitcnt vmcnt(3)
  s_branch L_body
L_clear:
  s_lshl_b32 s60, s27, 11
  s_add_u32 s56, s46, s60
  s_addc_u32 s57, s47, 0
  s_mov_b32 s72, 0
  s_atomic_swap s72, s[56:57], 0 glc
  s_mov_b32 s73, 0
  s_atomic_swap s73, s[56:57], 256 glc
  s_mov_b32 s74, 0
  s_atomic_swap s74, s[56:57], 512 glc
  s_mov_b32 s75, 0
  s_atomic_swap s75, s[56:57], 768 glc
  s_mov_b32 s76, 0
  s_atomic_swap s76, s[56:57], 1024 glc
  s_mov_b32 s77, 0
  s_atomic_swap s77, s[56:57], 1280 glc
  s_mov_b32 s78, 0
  s_atomic_swap s78, s[56:57], 1536 glc
  s_mov_b32 s79, 0
  s_atomic_swap s79, s[56:57], 1792 glc
  s_cmp_eq_u32 s27, 2
  s_cselect_b32 s60, 64, 0
  s_cselect_b32 s63, 128, 8
  s_add_u32 s60, s60, s2
  s_add_u32 s52, s44, s60
  s_addc_u32 s53, s45, 0
  s_waitcnt lgkmcnt(0)
  s_mov_b32 s72, s63
  s_atomic_or s72, s[52:53], 0 glc
  s_mov_b32 s73, s63
  s_atomic_or s73, s[52:53], 16 glc
  s_mov_b32 s74, s63
  s_atomic_or s74, s[52:53], 32 glc
  s_mov_b32 s75, s63
  s_atomic_or s75, s[52:53], 48 glc
  s_branch L_cleared
L_code_end:
.section .rodata,"a"
.p2align 6
.amdhsa_kernel standalone__depthwise_separable__vision_kernel
  .amdhsa_next_free_vgpr 172
  .amdhsa_next_free_sgpr 84
  .amdhsa_accum_offset 172
  .amdhsa_group_segment_fixed_size 0
  .amdhsa_kernarg_size 48
  .amdhsa_user_sgpr_count 2
  .amdhsa_user_sgpr_kernarg_segment_ptr 1
  .amdhsa_system_sgpr_workgroup_id_x 1
  .amdhsa_float_denorm_mode_32 3
.end_amdhsa_kernel
```
